```python
import torch

def _softmax(x, axis=-1):
    return torch.softmax(x, dim=axis)
def _gelu(x):
    return torch.nn.functional.gelu(x, approximate="tanh")
def _silu(x):
    return torch.nn.functional.silu(x)
def _sigmoid(x):
    return torch.sigmoid(x)
def _layernorm(x, axis=-1, eps=1e-5):
    m = x.mean(dim=axis, keepdim=True)
    v = x.var(dim=axis, keepdim=True, unbiased=False)
    return (x - m) / torch.sqrt(v + eps)
def _scatter_add(tgt, idx, src, axis=0):
    return tgt.clone().index_add_(axis, idx, src)
def _segment_sum(src, seg, n):
    out = torch.zeros((n,) + src.shape[1:], dtype=src.dtype)
    return out.index_add_(0, seg, src)
def _pad(x, pw):
    flat = tuple(v for pair in reversed(pw) for v in pair)
    return torch.nn.functional.pad(x, flat)

kernel_name = 'standalone__deepnorm__sampling'

def setup_inputs():

    _w = (lambda a: (lambda t: t.to(torch.bfloat16) if t.is_floating_point() else t)(torch.as_tensor(a)))
    B, S, D = 1024, 32, 448
    return {
        "x": _w((lambda *s: torch.randn(*s, dtype=torch.bfloat16) * 0.05)(B, S, D)),
        "f": _w((lambda *s: torch.randn(*s, dtype=torch.bfloat16) * 0.05)(B, S, D)),
        "g": _w((lambda *s: torch.randn(*s, dtype=torch.bfloat16) * 0.05)(D) + 1.0),
        "b": _w((lambda *s: torch.randn(*s, dtype=torch.bfloat16) * 0.4)(D)),
        "alpha": _w(float(2.0)),
    }

def reference(x, f, g, b, alpha):
    return _layernorm(alpha * x + f, axis=-1) * g + b
```

```asm
; @launch grid=(256,1,1) block=(704,1,1) lds=0
.amdgcn_target "amdgcn-amd-amdhsa--gfx950"
.text
.globl standalone__deepnorm__sampling_kernel
.p2align 12
.p2align 8
.type standalone__deepnorm__sampling_kernel,@function
standalone__deepnorm__sampling_kernel:
    s_load_dwordx16 s[4:19], s[0:1], 0
    s_cmp_ge_u32 s2, 256
    s_cbranch_scc1 L_end
    v_readfirstlane_b32 s32, v0
    s_cmp_ge_u32 s32, 64
    s_cbranch_scc1 L_main
    s_cmp_ge_u32 s2, 27
    s_cbranch_scc1 L_vend
L_voter:
    s_mul_hi_u32 s54, s2, 0x1c71c71d
    s_mul_i32 s54, s54, 9
    s_sub_u32 s54, s2, s54
    s_mul_hi_u32 s55, s54, 0x55555556
    s_mul_i32 s56, s55, 3
    s_sub_u32 s56, s54, s56
    s_add_u32 s56, s56, 1
    s_lshl_b32 s56, s56, 8
    s_add_u32 s56, s56, s2
    s_lshl_b32 s56, s56, 15
    s_add_u32 s57, s56, 0x2200
    s_getreg_b32 s58, hwreg(HW_REG_XCC_ID, 2, 1)
    s_lshl_b32 s54, s54, 1
    s_add_u32 s59, s2, 18
    s_lshl_b32 s59, s58, s59
    s_cmp_lt_u32 s2, 4
    s_cselect_b32 s59, s59, 0
    s_add_u32 s59, s59, 0x1000000
    s_xor_b32 s58, s58, 1
    s_cmp_eq_u32 s55, 1
    s_waitcnt lgkmcnt(0)
    s_cselect_b64 s[4:5], s[6:7], s[4:5]
    s_cmp_eq_u32 s55, 2
    s_cselect_b64 s[4:5], s[14:15], s[4:5]
    s_load_dword s60, s[4:5], s56
    s_load_dword s61, s[4:5], s57
    s_waitcnt lgkmcnt(1)
    s_getreg_b32 s56, hwreg(HW_REG_IB_STS, 8, 1)
    s_xor_b32 s56, s56, s58
    s_lshl_b32 s56, s56, s54
    s_add_u32 s59, s59, s56
    s_atomic_add s59, s[16:17], 0
L_vend:
    s_endpgm
L_main:
    s_lshr_b32 s32, s32, 6
    v_and_b32 v4, 7, v0
    v_and_b32 v5, 48, v0
    v_and_b32 v3, 8, v0
    v_and_b32 v6, 3, v0
    v_lshlrev_b32 v5, 3, v5
    v_lshl_or_b32 v0, v4, 4, v5
    s_bitcmp1_b32 0x784, s32
    s_cselect_b32 s36, 0x800, 0
    s_lshl_b32 s50, s2, 4
    s_and_b32 s50, s50, 0x800
    s_xor_b32 s36, s36, s50
    s_mul_i32 s50, s32, 3
    s_sub_u32 s50, s50, 3
    s_lshr_b32 s50, 0x14c14e4, s50
    s_and_b32 s50, s50, 7
    s_movk_i32 s42, 896
    s_mul_i32 s50, s50, s42
    v_add_u32 v105, s50, v0
    v_add_u32 v106, 3200, v0
    s_and_b32 s51, s2, 0xf9
    s_and_b32 s52, s2, 2
    s_lshl1_add_u32 s51, s52, s51
    s_lshl_b32 s51, s51, 13
    s_add_u32 s51, s51, s36
    s_add_u32 s51, s51, 192
    v_lshl_add_u32 v3, v3, 11, s51
    s_lshr_b32 s51, s2, 1
    s_xor_b32 s51, s51, s2
    s_lshl_b32 s52, s32, 1
    s_xor_b32 s51, s51, s52
    s_bitcmp1_b32 s51, 2
    s_cselect_b32 s34, 0x55, 0x2a
    s_lshl_b32 s34, s34, 12
    s_mov_b32 s33, 0
    s_brev_b32 s43, 1
    s_and_b32 s50, s34, 0x1000
    s_add_u32 s50, s50, s33
    v_add_u32 v4, s50, v3
    v_mul_hi_u32_u24 v1, 9586981, v4
    v_lshl_add_u32 v4, v4, 1, v106
    v_mad_u32_u24 v1, v1, s42, v105
    s_lshr_b32 s34, s34, 1
    v_xor_b32 v3, 0x2000, v3
    v_sub_u32 v4, v4, v1
    s_add_u32 s33, s33, 0x200000
    v_and_or_b32 v1, v4, s43, v1
    s_mov_b32 s22, 29360128
    s_mov_b32 s23, 0x20000
    s_mov_b64 s[26:27], s[22:23]
    s_mov_b32 s40, -1
    s_mov_b32 s41, 0xffff
    v_mov_b64 v[44:45], 0
    v_mov_b64 v[46:47], 0
    v_mov_b64 v[52:53], 0
    v_mov_b64 v[54:55], 0
    v_mov_b64 v[84:85], 0
    s_waitcnt lgkmcnt(0)
    s_mov_b64 s[20:21], s[4:5]
    s_mov_b64 s[24:25], s[6:7]
    global_load_ushort v84, v85, s[12:13]
    buffer_load_dwordx4 v[40:43], v1, s[20:23], 0 offen nt
    buffer_load_dwordx4 v[48:51], v1, s[24:27], 0 offen nt
    s_mov_b64 exec, s[40:41]
    buffer_load_dwordx4 v[44:47], v1, s[20:23], 0 offen offset:512 nt
    buffer_load_dwordx4 v[52:55], v1, s[24:27], 0 offen offset:512 nt
    global_load_dwordx4 v[112:115], v0, s[8:9] offset:512
    global_load_dwordx4 v[120:123], v0, s[10:11] offset:512
    s_mov_b64 exec, -1
    global_load_dwordx4 v[108:111], v0, s[8:9]
    global_load_dwordx4 v[116:119], v0, s[10:11]
    s_mov_b64 s[28:29], s[14:15]
    s_mov_b64 s[30:31], s[22:23]
    s_mov_b32 s35, 0
    s_mov_b32 s38, 0xffff0000
    v_mov_b32 v104, 0x3727c5ac
    v_mov_b32 v107, 0
    v_mov_b32 v90, 0xbb124925
    v_mov_b32 v91, 0x3b124925
    v_lshlrev_b32 v6, 4, v6
    v_mov_b32 v94, 0x3f80
    v_mov_b32 v95, 0
    v_lshlrev_b64 v[94:95], v6, v[94:95]
    v_mov_b32 v100, 0x3f803f80
    v_mov_b32 v101, v100
    v_mov_b32 v102, v100
    v_mov_b32 v103, v100
    s_lshl_b32 s53, s36, 1
    s_mov_b32 s36, 0
    s_and_b32 s50, s4, s53
    s_cselect_b32 s50, 0x2a, 0
    s_or_b32 s36, s36, s50
    s_and_b32 s50, s6, s53
    s_cselect_b32 s50, 0xa80, 0
    s_or_b32 s36, s36, s50
    s_and_b32 s50, s14, s53
    s_cselect_b32 s50, 0x2a000, 0
    s_or_b32 s36, s36, s50
    s_lshr_b32 s50, s2, 5
    s_xor_b32 s50, s50, s2
    s_bitcmp1_b32 s50, 2
    s_cselect_b32 s50, 0x3c0000, 0
    s_or_b32 s36, s36, s50
    s_xor_b32 s50, s4, s14
    s_bitcmp1_b32 s50, 12
    s_cselect_b32 s49, 0x2a, 0
    s_cselect_b32 s50, s32, 0
    s_bitcmp1_b32 0x556, s50
    s_cselect_b32 s44, -1, 0
    s_bitcmp1_b32 0x6, s50
    s_cselect_b32 s45, -1, 0
    s_and_b32 s37, s2, 3
    s_add_u32 s37, s37, 18
    s_waitcnt vmcnt(8)
    v_lshlrev_b64 v[92:93], v6, v[84:85]
    v_lshl_or_b32 v96, v84, 16, v84
    v_lshl_or_b32 v97, v84, 16, v84
    v_lshl_or_b32 v98, v84, 16, v84
    v_lshl_or_b32 v99, v84, 16, v84
    s_waitcnt vmcnt(4)
    s_branch L_body
L_loop:
    s_waitcnt vmcnt(2)
L_body:
    v_mfma_f32_16x16x32_bf16 v[80:83], v[96:99], v[40:43], 0
    v_mfma_f32_16x16x32_bf16 v[80:83], v[100:103], v[48:51], v[80:83]
    v_mfma_f32_16x16x32_bf16 v[80:83], v[96:99], v[44:47], v[80:83]
    v_mfma_f32_16x16x32_bf16 v[80:83], v[100:103], v[52:55], v[80:83]
    s_and_b32 s50, s34, 0x1000
    s_add_u32 s50, s50, s33
    v_mov_b32 v2, v1
    v_add_u32 v4, s50, v3
    v_mul_hi_u32_u24 v1, 9586981, v4
    v_lshl_add_u32 v4, v4, 1, v106
    v_mad_u32_u24 v1, v1, s42, v105
    v_sub_u32 v4, v4, v1
    v_add_f32_dpp v80, v80, v80 quad_perm:[1,0,3,2] row_mask:0xf bank_mask:0xf
    v_and_or_b32 v1, v4, s43, v1
    s_lshr_b32 s34, s34, 1
    v_add_f32_dpp v80, v80, v80 quad_perm:[2,3,0,1] row_mask:0xf bank_mask:0xf
    s_add_u32 s33, s33, 0x200000
    v_xor_b32 v3, 0x2000, v3
    v_add_f32_dpp v80, v80, v80 row_half_mirror row_mask:0xf bank_mask:0xf
    v_pk_mul_f32 v[84:85], v[80:81], v[90:91] op_sel_hi:[0,0]
    v_pk_mul_f32 v[86:87], v[80:81], v[90:91] op_sel_hi:[0,0]
    s_cmp_eq_u32 s33, 0xe00000
    s_cselect_b32 s33, 0x400000, s33
    v_mfma_f32_4x4x4_16b_bf16 v[56:59], v[92:93], v[40:41], v[84:87]
    v_mfma_f32_4x4x4_16b_bf16 v[60:63], v[92:93], v[42:43], v[84:87]
    v_mfma_f32_4x4x4_16b_bf16 v[64:67], v[92:93], v[44:45], v[84:87]
    v_mfma_f32_4x4x4_16b_bf16 v[68:71], v[92:93], v[46:47], v[84:87]
    v_mfma_f32_4x4x4_16b_bf16 v[56:59], v[94:95], v[48:49], v[56:59]
    v_mfma_f32_4x4x4_16b_bf16 v[60:63], v[94:95], v[50:51], v[60:63]
    v_mfma_f32_4x4x4_16b_bf16 v[64:67], v[94:95], v[52:53], v[64:67]
    v_mfma_f32_4x4x4_16b_bf16 v[68:71], v[94:95], v[54:55], v[68:71]
    s_cmp_eq_u32 s35, 6
    s_cbranch_scc1 L_nogb
    buffer_load_dwordx4 v[40:43], v1, s[20:23], 0 offen nt
    buffer_load_dwordx4 v[48:51], v1, s[24:27], 0 offen nt
    s_mov_b64 exec, s[40:41]
    buffer_load_dwordx4 v[44:47], v1, s[20:23], 0 offen offset:512 nt
    buffer_load_dwordx4 v[52:55], v1, s[24:27], 0 offen offset:512 nt
    s_mov_b64 exec, -1
    s_cmp_eq_u32 s35, 0
    s_cbranch_scc1 L_gb
L_nogb:
    v_pk_mul_f32 v[88:89], v[56:57], v[56:57]
    v_pk_fma_f32 v[88:89], v[58:59], v[58:59], v[88:89]
    v_pk_fma_f32 v[88:89], v[60:61], v[60:61], v[88:89]
    v_pk_fma_f32 v[88:89], v[62:63], v[62:63], v[88:89]
    s_mov_b64 exec, s[40:41]
    v_pk_fma_f32 v[88:89], v[64:65], v[64:65], v[88:89]
    v_pk_fma_f32 v[88:89], v[66:67], v[66:67], v[88:89]
    v_pk_fma_f32 v[88:89], v[68:69], v[68:69], v[88:89]
    v_pk_fma_f32 v[88:89], v[70:71], v[70:71], v[88:89]
    s_mov_b64 exec, -1
    v_add_f32 v4, v88, v89
    s_nop 1
    v_add_f32_dpp v4, v4, v4 quad_perm:[1,0,3,2] row_mask:0xf bank_mask:0xf
    s_nop 1
    v_add_f32_dpp v4, v4, v4 quad_perm:[2,3,0,1] row_mask:0xf bank_mask:0xf
    s_nop 1
    v_add_f32_dpp v4, v4, v4 row_half_mirror row_mask:0xf bank_mask:0xf
    s_nop 1
    v_mfma_f32_16x16x4_f32 v[80:83], v91, v4, v[104:107]
    v_pk_mul_f32 v[56:57], v[56:57], v[8:9]
    v_pk_mul_f32 v[58:59], v[58:59], v[10:11]
    v_pk_mul_f32 v[60:61], v[60:61], v[12:13]
    v_pk_mul_f32 v[62:63], v[62:63], v[14:15]
    v_pk_mul_f32 v[64:65], v[64:65], v[16:17]
    v_pk_mul_f32 v[66:67], v[66:67], v[18:19]
    v_pk_mul_f32 v[68:69], v[68:69], v[20:21]
    v_pk_mul_f32 v[70:71], v[70:71], v[22:23]
    s_cmp_eq_u32 s35, 6
    s_cbranch_scc1 L_last
    v_rsq_f32 v4, v80
    s_nop 0
    v_pk_fma_f32 v[56:57], v[56:57], v[4:5], v[24:25] op_sel_hi:[1,0,1]
    v_pk_fma_f32 v[58:59], v[58:59], v[4:5], v[26:27] op_sel_hi:[1,0,1]
    v_pk_fma_f32 v[60:61], v[60:61], v[4:5], v[28:29] op_sel_hi:[1,0,1]
    v_pk_fma_f32 v[62:63], v[62:63], v[4:5], v[30:31] op_sel_hi:[1,0,1]
    v_cvt_pk_bf16_f32 v72, v56, v57
    v_cvt_pk_bf16_f32 v73, v58, v59
    v_cvt_pk_bf16_f32 v74, v60, v61
    v_cvt_pk_bf16_f32 v75, v62, v63
    buffer_store_dwordx4 v[72:75], v2, s[28:31], 0 offen sc0 sc1
    s_mov_b64 exec, s[40:41]
    v_pk_fma_f32 v[64:65], v[64:65], v[4:5], v[32:33] op_sel_hi:[1,0,1]
    v_pk_fma_f32 v[66:67], v[66:67], v[4:5], v[34:35] op_sel_hi:[1,0,1]
    v_pk_fma_f32 v[68:69], v[68:69], v[4:5], v[36:37] op_sel_hi:[1,0,1]
    v_pk_fma_f32 v[70:71], v[70:71], v[4:5], v[38:39] op_sel_hi:[1,0,1]
    v_cvt_pk_bf16_f32 v76, v64, v65
    v_cvt_pk_bf16_f32 v77, v66, v67
    v_cvt_pk_bf16_f32 v78, v68, v69
    v_cvt_pk_bf16_f32 v79, v70, v71
    buffer_store_dwordx4 v[76:79], v2, s[28:31], 0 offen offset:512 sc0 sc1
    s_mov_b64 exec, -1
    s_add_u32 s35, s35, 1
    s_cmp_lg_u32 s35, 1
    s_barrier
    s_cbranch_scc1 L_loop
    s_load_dword s39, s[16:17], 0
    s_mov_b32 s53, 0
    s_waitcnt lgkmcnt(0)
L_check:
    s_lshr_b32 s50, s39, 24
    s_cmp_lg_u32 s50, 27
    s_cbranch_scc1 L_slow
    s_xor_b32 s39, s39, s36
    s_lshr_b32 s50, s39, 6
    s_lshr_b32 s51, s39, 12
    s_xor_b32 s52, s39, s50
    s_xor_b32 s50, s50, s51
    s_andn2_b32 s50, s50, s52
    s_and_b32 s47, s52, s49
    s_and_b32 s46, s47, 40
    s_cmp_eq_u32 s46, 8
    s_cselect_b32 s48, 4, 0
    s_and_b32 s46, s47, 10
    s_cmp_eq_u32 s46, 2
    s_cselect_b32 s48, 2, s48
    s_lshl_b32 s46, s48, 21
    s_add_u32 s33, s33, s46
    s_or_b32 s48, s48, 0x50000
    s_and_b32 s50, s50, 0x2a
    s_mul_i32 s50, s50, 3
    s_bfe_u32 s50, s50, 0x50001
    s_mul_i32 s50, s50, 33
    s_bfe_u32 s50, s50, s48
    s_and_b32 s51, s51, 0x2a
    s_mul_i32 s51, s51, 3
    s_bfe_u32 s51, s51, 0x50001
    s_mul_i32 s51, s51, 33
    s_bfe_u32 s51, s51, s48
    s_and_b32 s52, s52, 0x2a
    s_mul_i32 s52, s52, 3
    s_bfe_u32 s52, s52, 0x50001
    s_mul_i32 s52, s52, 33
    s_bfe_u32 s52, s52, s48
    s_lshr_b32 s46, s52, 1
    s_and_b32 s46, s46, s44
    s_lshr_b32 s47, s52, 2
    s_and_b32 s47, s47, s45
    s_or_b32 s46, s46, s47
    s_andn2_b32 s50, s50, s46
    s_xor_b32 s50, s50, s51
    s_lshl_b32 s50, s50, 12
    s_bitcmp1_b32 s39, s37
    s_cselect_b32 s51, -1, 0
    s_xor_b32 s34, s50, s51
L_decided:
    s_branch L_loop
L_gb:
    s_waitcnt vmcnt(4)
    v_lshlrev_b32 v8, 16, v108
    v_and_b32 v9, s38, v108
    v_lshlrev_b32 v10, 16, v109
    v_and_b32 v11, s38, v109
    v_lshlrev_b32 v12, 16, v110
    v_and_b32 v13, s38, v110
    v_lshlrev_b32 v14, 16, v111
    v_and_b32 v15, s38, v111
    v_lshlrev_b32 v16, 16, v112
    v_and_b32 v17, s38, v112
    v_lshlrev_b32 v18, 16, v113
    v_and_b32 v19, s38, v113
    v_lshlrev_b32 v20, 16, v114
    v_and_b32 v21, s38, v114
    v_lshlrev_b32 v22, 16, v115
    v_and_b32 v23, s38, v115
    v_lshlrev_b32 v24, 16, v116
    v_and_b32 v25, s38, v116
    v_lshlrev_b32 v26, 16, v117
    v_and_b32 v27, s38, v117
    v_lshlrev_b32 v28, 16, v118
    v_and_b32 v29, s38, v118
    v_lshlrev_b32 v30, 16, v119
    v_and_b32 v31, s38, v119
    v_lshlrev_b32 v32, 16, v120
    v_and_b32 v33, s38, v120
    v_lshlrev_b32 v34, 16, v121
    v_and_b32 v35, s38, v121
    v_lshlrev_b32 v36, 16, v122
    v_and_b32 v37, s38, v122
    v_lshlrev_b32 v38, 16, v123
    v_and_b32 v39, s38, v123
    s_branch L_nogb
L_last:
    v_rsq_f32 v4, v80
    s_nop 0
    v_pk_fma_f32 v[56:57], v[56:57], v[4:5], v[24:25] op_sel_hi:[1,0,1]
    v_pk_fma_f32 v[58:59], v[58:59], v[4:5], v[26:27] op_sel_hi:[1,0,1]
    v_pk_fma_f32 v[60:61], v[60:61], v[4:5], v[28:29] op_sel_hi:[1,0,1]
    v_pk_fma_f32 v[62:63], v[62:63], v[4:5], v[30:31] op_sel_hi:[1,0,1]
    v_cvt_pk_bf16_f32 v72, v56, v57
    v_cvt_pk_bf16_f32 v73, v58, v59
    v_cvt_pk_bf16_f32 v74, v60, v61
    v_cvt_pk_bf16_f32 v75, v62, v63
    buffer_store_dwordx4 v[72:75], v2, s[28:31], 0 offen
    s_mov_b64 exec, s[40:41]
    v_pk_fma_f32 v[64:65], v[64:65], v[4:5], v[32:33] op_sel_hi:[1,0,1]
    v_pk_fma_f32 v[66:67], v[66:67], v[4:5], v[34:35] op_sel_hi:[1,0,1]
    v_pk_fma_f32 v[68:69], v[68:69], v[4:5], v[36:37] op_sel_hi:[1,0,1]
    v_pk_fma_f32 v[70:71], v[70:71], v[4:5], v[38:39] op_sel_hi:[1,0,1]
    v_cvt_pk_bf16_f32 v76, v64, v65
    v_cvt_pk_bf16_f32 v77, v66, v67
    v_cvt_pk_bf16_f32 v78, v68, v69
    v_cvt_pk_bf16_f32 v79, v70, v71
    buffer_store_dwordx4 v[76:79], v2, s[28:31], 0 offen offset:512
L_end:
    s_endpgm
L_slow:
    s_bitcmp1_b32 s39, 31
    s_cbranch_scc1 L_decided
    s_add_u32 s53, s53, 1
    s_lshr_b32 s50, s2, 3
    s_add_u32 s50, s50, s32
    s_cmp_ge_u32 s53, 48
    s_cselect_b32 s50, 1, s50
    s_cmp_lg_u32 s50, 1
    s_cbranch_scc1 L_reread
    s_cmp_ge_u32 s53, 24
    s_cselect_b32 s52, s43, 0
    s_or_b32 s50, s52, s39
    s_mov_b32 s51, s39
    s_atomic_cmpswap s[50:51], s[16:17], 0 glc
    s_waitcnt lgkmcnt(0)
    s_cmp_eq_u32 s50, s39
    s_cselect_b32 s52, s52, 0
    s_or_b32 s39, s50, s52
    s_branch L_check
L_reread:
    v_mov_b32 v5, 0
    global_load_dword v4, v5, s[16:17] nt
    s_waitcnt vmcnt(0)
    v_readfirstlane_b32 s39, v4
    s_branch L_check
.section .rodata,"a"
.p2align 6
.amdhsa_kernel standalone__deepnorm__sampling_kernel
  .amdhsa_next_free_vgpr 124
  .amdhsa_next_free_sgpr 64
  .amdhsa_accum_offset 124
  .amdhsa_group_segment_fixed_size 0
  .amdhsa_kernarg_size 64
  .amdhsa_user_sgpr_count 2
  .amdhsa_user_sgpr_kernarg_segment_ptr 1
  .amdhsa_system_sgpr_workgroup_id_x 1
  .amdhsa_float_denorm_mode_32 3
.end_amdhsa_kernel
```
